```python
import torch

def _softmax(x, axis=-1):
    return torch.softmax(x, dim=axis)
def _gelu(x):
    return torch.nn.functional.gelu(x, approximate="tanh")
def _silu(x):
    return torch.nn.functional.silu(x)
def _sigmoid(x):
    return torch.sigmoid(x)
def _layernorm(x, axis=-1, eps=1e-5):
    m = x.mean(dim=axis, keepdim=True)
    v = x.var(dim=axis, keepdim=True, unbiased=False)
    return (x - m) / torch.sqrt(v + eps)
def _scatter_add(tgt, idx, src, axis=0):
    return tgt.clone().index_add_(axis, idx, src)
def _segment_sum(src, seg, n):
    out = torch.zeros((n,) + src.shape[1:], dtype=src.dtype)
    return out.index_add_(0, seg, src)
def _pad(x, pw):
    flat = tuple(v for pair in reversed(pw) for v in pair)
    return torch.nn.functional.pad(x, flat)

kernel_name = 'gated_mix__sliding_block_cached__dense_activation_mish__decode'

def setup_inputs():

    _w = (lambda a: (lambda t: t.to(torch.bfloat16) if t.is_floating_point() else t)(torch.as_tensor(a)))
    def _A_setup():
        B, Sq, D = 1, 1, 512
        Hq, Hkv, Sk, Dh = 32, 8, 65536, 128
        assert Hq % Hkv == 0, (Hq, Hkv)
        return {
            "x": _w((lambda *s: torch.randn(*s, dtype=torch.bfloat16) * 0.05)(B, Sq, D)),
            "k_cache": _w((lambda *s: torch.randn(*s, dtype=torch.bfloat16) * 6.4)(B, Hkv, Sk, Dh)),
            "v_cache": _w((lambda *s: torch.randn(*s, dtype=torch.bfloat16) * 0.4)(B, Hkv, Sk, Dh)),
            "wq": _w((lambda *s: torch.randn(*s, dtype=torch.bfloat16) * 6.4)(D, Hq * Dh) * (D ** -0.5)),
            "wo": _w((lambda *s: torch.randn(*s, dtype=torch.bfloat16) * 0.4)(Hq * Dh, D) * ((Hq * Dh) ** -0.5)),
        }
    _A_in = _A_setup()

    def _B_setup():
        B, S, D, F = 1, 1, 512, 1792
        return {
            "x": _w((lambda *s: torch.randn(*s, dtype=torch.bfloat16) * 0.05)(B, S, D)),
            "w1": _w((lambda *s: torch.randn(*s, dtype=torch.bfloat16) * 12.8)(D, F) * (D ** -0.5)),
            "b1": _w((lambda *s: torch.randn(*s, dtype=torch.bfloat16) * 0.05)(F)),
            "w2": _w((lambda *s: torch.randn(*s, dtype=torch.bfloat16) * 0.05)(F, D) * (F ** -0.5)),
        }
    _B_in = _B_setup()

    return {
        "A_x": _A_in["x"],
        "A_k_cache": _A_in["k_cache"],
        "A_v_cache": _A_in["v_cache"],
        "A_wq": _A_in["wq"],
        "A_wo": _A_in["wo"],
        "B_x": _B_in["x"],
        "B_w1": _B_in["w1"],
        "B_b1": _B_in["b1"],
        "B_w2": _B_in["w2"],
        "gate_w": _w((lambda *s: torch.randn(*s, dtype=torch.bfloat16) * 0.05)(512) * 16.0),
    }

def reference(A_x, A_k_cache, A_v_cache, A_wq, A_wo, B_x, B_w1, B_b1, B_w2, gate_w):
    def _A_ref(x, k_cache, v_cache, wq, wo):
        B, Sq, D = x.shape
        Hq, Dh = 32, 128
        Hkv, Sk = k_cache.shape[1], k_cache.shape[2]
        W = min(4096, max(256, Sk // 4))
        rep = Hq // Hkv
        q = (lambda x, *d: x.permute(*d))((x @ wq).reshape(B, Sq, Hq, Dh), 0, 2, 1, 3)
        k = (lambda x, n, axis: torch.repeat_interleave(x, n, dim=axis))(k_cache[:, :, Sk - W:, :], rep, axis=1)
        v = (lambda x, n, axis: torch.repeat_interleave(x, n, dim=axis))(v_cache[:, :, Sk - W:, :], rep, axis=1)
        scores = torch.einsum("bhqd,bhkd->bhqk", q, k) * (Dh ** -0.5)
        p = _softmax(scores, axis=-1)
        o = torch.einsum("bhqk,bhkd->bhqd", p, v)
        return (lambda x, *d: x.permute(*d))(o, 0, 2, 1, 3).reshape(B, Sq, Hq * Dh) @ wo

    def _B_ref(x, w1, b1, w2):
        h = torch.einsum("bsd,df->bsf", x, w1) + b1
        sp = torch.log1p(torch.exp(-torch.abs(h))) + torch.where(h > 0, h, torch.zeros_like(h))
        act = h * torch.tanh(sp)
        return torch.einsum("bsf,fd->bsd", act, w2)

    x = A_x
    g = _sigmoid((x * gate_w).sum(-1, keepdims=True))
    a = _A_ref(x, A_k_cache, A_v_cache, A_wq, A_wo)
    b = _B_ref(x, B_w1, B_b1, B_w2)
    return g * a + (1 - g) * b
```

```asm
; @launch grid=(256,1,1) block=(256,1,1) lds=13312
.amdgcn_target "amdgcn-amd-amdhsa--gfx950"
.text
.globl gated_mix__sliding_block_cached__dense_activation_mish__decode_kernel
.p2align 8
.type gated_mix__sliding_block_cached__dense_activation_mish__decode_kernel,@function
gated_mix__sliding_block_cached__dense_activation_mish__decode_kernel:
L_start:
    s_load_dwordx16 s[4:19], s[0:1], 0
    s_load_dwordx16 s[20:35], s[0:1], 40
    s_getpc_b64 s[54:55]
    v_mul_u32_u24 v13, 24, v0
    global_load_dword v14, v13, s[54:55] offset:128
    s_mul_i32 s38, s2, 0x20404
    s_and_b32 s38, s38, 0x301f80
    v_lshrrev_b32 v1, 3, v0
    v_and_b32 v2, 7, v0
    v_lshlrev_b32 v2, 4, v2
    v_lshl_add_u32 v3, v1, 15, v2
    v_add_u32 v3, s38, v3
    s_movk_i32 s39, 0x2000
    v_lshrrev_b32 v4, 12, v3
    v_and_b32 v4, -8, v4
    s_waitcnt lgkmcnt(0)
    global_load_dwordx2 v[50:51], v4, s[4:5]
    global_load_dwordx4 v[84:87], v3, s[10:11] nt
    v_add_u32 v3, s39, v3
    global_load_dwordx4 v[88:91], v3, s[10:11] nt
    v_add_u32 v3, s39, v3
    global_load_dwordx4 v[92:95], v3, s[10:11] nt
    v_add_u32 v3, s39, v3
    global_load_dwordx4 v[96:99], v3, s[10:11] nt
    s_and_b32 s39, s2, 0xf8
    s_lshl_b32 s39, s39, 14
    s_and_b32 s40, s38, 0x1c00
    s_add_u32 s39, s39, s40
    s_addk_i32 s39, 0x180
    v_lshrrev_b32 v9, 4, v0
    v_lshl_add_u32 v9, v9, 13, s39
    v_lshl_add_u32 v9, v2, 2, v9
    s_mov_b32 exec_lo, 0x30003
    s_mov_b32 exec_hi, 0x30003
    global_load_dword v14, v9, s[10:11]
    s_mov_b64 exec, -1
    s_load_dword s37, s[34:35], 0
    s_cmpk_ge_u32 s2, 256
    s_cbranch_scc1 L_end
    s_lshr_b32 s98, s38, 20
    s_and_b32 s96, s2, 7
    s_xor_b32 s101, s96, 7
    s_lshl2_add_u32 s101, s101, s98
    s_cmp_lt_u32 s101, 28
    s_cselect_b32 s36, -1, 0
    s_and_b32 s38, s2, 0xe0
    v_add_u32 v9, s38, v1
    v_mul_u32_u24 v5, 7168, v9
    s_lshl_b32 s40, s101, 7
    v_add3_u32 v5, v5, v2, s40
    v_and_b32 v5, s36, v5
    v_lshlrev_b32 v6, 2, v9
    s_barrier
    global_load_dword v17, v6, s[4:5]
    global_load_dwordx4 v[72:75], v5, s[22:23] nt
    global_load_dwordx4 v[76:79], v5, s[22:23] offset:3584 nt
    v_readfirstlane_b32 s100, v0
    s_mul_i32 s61, s2, 0x1000200
    s_and_b32 s61, s61, 0x0701f000
    s_lshl4_add_u32 s61, s100, s61
    s_add_u32 s61, s61, 0xf00000
    v_and_b32 v10, 3, v0
    v_lshl_add_u32 v15, v10, 4, s61
    v_bfe_u32 v11, v0, 2, 2
    v_lshl_add_u32 v15, v11, 8, v15
    v_bfe_u32 v12, v0, 4, 2
    v_lshl_add_u32 v15, v12, 6, v15
    global_load_dwordx4 v[124:127], v15, s[6:7] nt
    v_xor_b32 v15, 0x80000, v15
    v_and_b32 v7, 63, v0
    v_lshlrev_b32 v13, 4, v7
    v_add_u32 v16, s61, v13
    s_lshr_b32 s100, s100, 6
    v_mul_u32_u24 v38, 320, v10
    v_lshl_add_u32 v38, v12, 6, v38
    v_lshl_add_u32 v38, v11, 4, v38
    v_lshlrev_b32 v36, 4, v10
    s_lshl_b32 s38, s100, 2
    v_add_u32 v37, s38, v36
    s_mul_i32 s38, s100, 2176
    v_mul_u32_u24 v39, 544, v10
    v_lshl_add_u32 v39, v12, 7, v39
    v_lshl_add_u32 v39, v11, 4, v39
    v_add_u32 v39, s38, v39
    global_load_dwordx4 v[128:131], v15, s[6:7] nt
    v_xor_b32 v15, 0xc0000, v15
    s_lshr_b32 s97, s2, 3
    s_lshr_b32 s53, s2, 5
    s_xor_b32 s99, s53, 4
    s_lshl2_add_u32 s49, s96, s98
    s_mov_b32 s41, 0x05040100
    s_mov_b32 s42, 0x07060302
    s_mov_b32 s45, 0xffffff00
    v_and_b32 v8, 7, v1
    s_lshl_b32 s39, s100, 8
    v_lshl_add_u32 v23, v2, 1, s39
    v_lshl_add_u32 v23, v8, 2, v23
    s_lshl_b32 s40, s100, 6
    v_add_u32 v25, s40, v13
    s_add_u32 s58, s34, 786432
    s_addc_u32 s59, s35, 0
    global_load_dwordx4 v[132:135], v15, s[6:7] nt
    v_xor_b32 v15, 0x80000, v15
    s_lshl_b32 s38, s49, 11
    s_lshl_b32 s39, s53, 8
    s_add_u32 s38, s38, s39
    s_add_u32 s38, s38, 4096
    v_add_u32 v26, s38, v25
    s_lshl_b32 s38, s101, 11
    s_add_u32 s38, s38, 69632
    s_add_u32 s39, s39, s38
    v_add_u32 v27, s39, v25
    s_add_u32 s38, s38, s40
    v_bfe_u32 v9, v7, 1, 3
    v_lshl_add_u32 v19, v9, 8, s38
    v_and_b32 v9, 48, v7
    v_add_u32 v19, v19, v9
    global_load_dwordx4 v[136:139], v15, s[6:7] nt
    v_xor_b32 v15, 0xe0000, v15
    s_mov_b64 exec, 1
    v_xor_b32 v9, 0x100, v26
    global_load_dword v14, v9, s[34:35] sc1
    s_mov_b64 exec, -1
    s_lshl2_add_u32 s40, s99, s100
    s_lshl_b32 s38, s40, 8
    s_add_u32 s38, s38, 1572864
    v_and_b32 v9, 15, v7
    v_lshl_add_u32 v28, v9, 2, s38
    v_lshl_add_u32 v28, v12, 7, v28
    v_lshl_add_u32 v29, v10, 4, s38
    v_lshl_add_u32 v29, v11, 7, v29
    v_lshl_add_u32 v9, v8, 2, v10
    s_lshl_b32 s38, s100, 6
    v_lshl_add_u32 v30, v9, 2, s38
    s_lshl_b32 s38, s40, 5
    v_lshl_add_u32 v31, v9, 1, s38
    v_mov_b32 v32, 1.0
    s_mov_b32 s32, 0x0f0f0f0f
    s_mov_b32 s33, 0
    s_lshl3_add_u32 s38, s49, s53
    s_lshl_b32 s38, s38, 8
    s_add_u32 s38, s38, 135168
    v_lshl_add_u32 v22, v8, 5, s38
    v_lshl_add_u32 v22, v10, 3, v22
    s_lshl_b32 s39, s101, 7
    v_lshrrev_b32 v9, 2, v0
    v_lshl_add_u32 v24, v9, 1, s39
    v_and_b32 v24, s36, v24
    s_lshl_b32 s38, s101, 16
    s_lshl_b32 s40, s99, 7
    s_add_u32 s38, s38, s40
    v_lshl_add_u32 v20, v1, 11, v2
    v_add_u32 v20, s38, v20
    v_and_b32 v20, s36, v20
    s_lshl_b32 s38, s49, 17
    s_lshl_b32 s39, s100, 15
    s_add_u32 s38, s38, s39
    s_add_u32 s38, s38, s40
    s_addk_i32 s38, 0x1000
    v_lshrrev_b32 v11, 5, v7
    v_lshl_add_u32 v3, v11, 14, v2
    v_and_b32 v9, 3, v8
    v_lshl_add_u32 v3, v9, 10, v3
    v_add_u32 v3, s38, v3
    v_add_u32 v4, 0x2000, v3
    s_lshl_b32 s38, s49, 14
    s_lshl_b32 s39, s100, 12
    s_add_u32 s38, s38, s39
    s_add_u32 s38, s38, 200704
    v_add_u32 v21, s38, v13
    s_and_b32 s38, s97, 7
    s_lshr_b32 s39, s97, 3
    s_lshl2_add_u32 s52, s38, s39
    s_lshl2_add_u32 s40, s96, s100
    s_lshl_b32 s38, s40, 14
    s_lshl_b32 s39, s97, 7
    s_add_u32 s38, s38, s39
    s_add_u32 s38, s38, 200704
    v_lshl_add_u32 v42, v8, 12, v2
    v_add_u32 v42, s38, v42
    s_lshl_b32 s38, s40, 11
    s_lshl3_add_u32 s38, s52, s38
    s_add_u32 s38, s38, 135168
    v_lshl_add_u32 v43, v2, 4, s38
    s_mul_i32 s38, s100, 544
    v_add_u32 v40, s38, v13
    s_cmp_lg_u32 s36, 0
    s_cselect_b32 s18, s41, 0x0c0c0c0c
    s_cselect_b32 s19, s42, 0x0c0c0c0c
    v_mov_b32 v48, 0
    v_mov_b32 v49, 0
    s_lshl_b32 s38, s96, 13
    s_lshl_b32 s39, s100, 9
    s_add_u32 s38, s38, s39
    s_add_u32 s38, s38, 4096
    v_and_b32 v9, 31, v7
    v_lshl_add_u32 v34, v9, 4, s38
    v_lshl_add_u32 v34, v11, 12, v34
    s_mul_i32 s38, s100, 320
    v_lshl_add_u32 v35, v9, 3, s38
    v_lshl_add_u32 v35, v11, 2, v35
    s_mov_b32 s47, 0x3db504f3
    s_mov_b32 s48, 0x3fb8aa3b
    s_mov_b32 s43, 0x0c0c0400
    s_mov_b32 s44, 0x04000c0c
    s_mov_b32 s46, 0
    s_mov_b32 s95, 0
    s_getreg_b32 s14, hwreg(HW_REG_XCC_ID, 0, 4)
    s_mov_b64 s[56:57], s[34:35]
    v_mov_b64 v[220:221], 0
    v_mov_b64 v[222:223], 0
    v_mov_b64 v[224:225], 0
    v_mov_b64 v[226:227], 0
    v_mov_b64 v[228:229], 0
    v_mov_b64 v[230:231], 0
    v_mov_b64 v[232:233], 0
    v_mov_b64 v[234:235], 0
    s_waitcnt lgkmcnt(0)
    s_add_u32 s37, s37, 0x9e3779b9
    s_and_b32 s38, s37, 0xff
    v_mov_b32 v44, s38
    s_bfe_u32 s38, s37, 0x80008
    v_mov_b32 v45, s38
    s_bfe_u32 s38, s37, 0x80010
    v_mov_b32 v46, s38
    s_lshr_b32 s38, s37, 24
    v_mov_b32 v47, s38
    s_xor_b32 s94, s37, s14
    s_and_b32 s20, s37, 0x7fffc0
    s_or_b32 s20, s20, 0x4b000000
    v_and_b32 v9, 1, v0
    v_mul_lo_u32 v116, v9, s20
    v_mov_b32 v117, v116
    v_mov_b32 v118, v116
    v_mov_b32 v119, v116
    s_waitcnt vmcnt(11)
    v_perm_b32 v100, v88, v84, s41
    v_perm_b32 v101, v88, v84, s42
    v_perm_b32 v102, v89, v85, s41
    v_perm_b32 v103, v89, v85, s42
    v_perm_b32 v104, v90, v86, s41
    v_perm_b32 v105, v90, v86, s42
    v_perm_b32 v106, v91, v87, s41
    v_perm_b32 v107, v91, v87, s42
    v_dot2_f32_bf16 v60, v100, v50, 0
    v_dot2_f32_bf16 v64, v104, v50, 0
    v_dot2_f32_bf16 v61, v101, v50, 0
    v_dot2_f32_bf16 v65, v105, v50, 0
    v_dot2_f32_bf16 v62, v102, v50, 0
    v_dot2_f32_bf16 v66, v106, v50, 0
    v_dot2_f32_bf16 v63, v103, v50, 0
    v_dot2_f32_bf16 v67, v107, v50, 0
    s_waitcnt vmcnt(9)
    v_perm_b32 v108, v96, v92, s41
    v_perm_b32 v109, v96, v92, s42
    v_perm_b32 v110, v97, v93, s41
    v_perm_b32 v111, v97, v93, s42
    v_perm_b32 v112, v98, v94, s41
    v_perm_b32 v113, v98, v94, s42
    v_perm_b32 v114, v99, v95, s41
    v_perm_b32 v115, v99, v95, s42
    v_dot2c_f32_bf16 v60, v108, v51
    v_dot2c_f32_bf16 v64, v112, v51
    v_dot2c_f32_bf16 v61, v109, v51
    v_dot2c_f32_bf16 v65, v113, v51
    v_dot2c_f32_bf16 v62, v110, v51
    v_dot2c_f32_bf16 v66, v114, v51
    v_dot2c_f32_bf16 v63, v111, v51
    v_dot2c_f32_bf16 v67, v115, v51
    v_permlane32_swap_b32 v60, v64
    v_permlane32_swap_b32 v61, v65
    v_permlane32_swap_b32 v62, v66
    v_permlane32_swap_b32 v63, v67
    v_add_f32 v60, v60, v64
    v_add_f32 v62, v62, v66
    v_add_f32 v61, v61, v65
    v_add_f32 v63, v63, v67
    v_permlane16_swap_b32 v60, v62
    v_add_f32 v60, v60, v62
    v_permlane16_swap_b32 v61, v63
    v_add_f32 v61, v61, v63
    v_add_f32_dpp v9, v60, v60 row_ror:8 row_mask:0xf bank_mask:0x3
    s_nop 0
    v_add_f32_dpp v9, v61, v61 row_ror:8 row_mask:0xf bank_mask:0xc
    ds_write_b32 v23, v9 offset:1536
    s_mov_b64 exec, 0xf
    s_waitcnt lgkmcnt(0)
    s_barrier
    ds_read_b128 v[100:103], v25 offset:1536
    ds_read_b128 v[104:107], v25 offset:1792
    ds_read_b128 v[108:111], v25 offset:2048
    ds_read_b128 v[112:115], v25 offset:2304
    s_waitcnt lgkmcnt(2)
    v_pk_add_f32 v[100:101], v[100:101], v[104:105]
    v_pk_add_f32 v[102:103], v[102:103], v[106:107]
    s_waitcnt lgkmcnt(0)
    v_pk_add_f32 v[108:109], v[108:109], v[112:113]
    v_pk_add_f32 v[110:111], v[110:111], v[114:115]
    v_pk_add_f32 v[100:101], v[100:101], v[108:109]
    v_pk_add_f32 v[102:103], v[102:103], v[110:111]
    v_and_or_b32 v100, v100, s45, v44
    v_and_or_b32 v101, v101, s45, v45
    v_and_or_b32 v102, v102, s45, v46
    v_and_or_b32 v103, v103, s45, v47
    v_xor_b32 v100, s14, v100
    global_store_dwordx4 v26, v[100:103], s[34:35]
    s_cmp_eq_u32 s49, 4
    s_cbranch_scc0 L_noin
    s_mov_b64 exec, 0xff
    global_store_dwordx4 v29, v[116:119], s[34:35] sc1
    s_nop 0
L_noin:
    s_nop 0
    v_mov_b64 v[116:117], v[100:101]
    v_mov_b64 v[118:119], v[102:103]
    s_mov_b64 exec, -1
    global_load_dwordx4 v[188:191], v13, s[4:5]
    global_load_dwordx4 v[192:195], v13, s[28:29]
    global_load_dwordx4 v[140:143], v15, s[6:7] nt
    v_xor_b32 v15, 0x80000, v15
    global_load_dwordx4 v[144:147], v15, s[6:7] nt
    v_xor_b32 v15, 0xc0000, v15
    global_load_dwordx4 v[148:151], v15, s[6:7] nt
    v_xor_b32 v15, 0x80000, v15
    global_load_dwordx4 v[152:155], v15, s[6:7] nt
    s_lshl_b32 s38, s96, 5
    s_add_u32 s38, s38, s97
    s_lshl2_add_u32 s38, s38, s100
    s_lshl_b32 s38, s38, 12
    s_addk_i32 s38, 0x180
    v_lshrrev_b32 v9, 1, v7
    v_and_b32 v10, 1, v7
    v_lshlrev_b32 v10, 6, v10
    v_lshl_add_u32 v9, v9, 10, v10
    v_add_u32 v10, s38, v9
    s_mov_b64 exec, 0xff
    global_load_dword v14, v10, s[12:13]
    s_lshl3_add_u32 s38, s101, s53
    s_lshl2_add_u32 s38, s38, s100
    s_lshl_b32 s38, s38, 11
    s_addk_i32 s38, 0x180
    s_and_b32 s38, s38, s36
    v_add_u32 v10, s38, v9
    s_mov_b64 exec, 0xf
    global_load_dword v14, v10, s[26:27]
    s_mov_b64 exec, -1
    s_waitcnt vmcnt(14)
    v_perm_b32 v100, v76, v72, s41
    v_perm_b32 v101, v76, v72, s42
    v_perm_b32 v102, v77, v73, s41
    v_perm_b32 v103, v77, v73, s42
    v_perm_b32 v104, v78, v74, s41
    v_perm_b32 v105, v78, v74, s42
    v_perm_b32 v106, v79, v75, s41
    v_perm_b32 v107, v79, v75, s42
    v_dot2_f32_bf16 v60, v100, v17, 0
    v_dot2_f32_bf16 v64, v104, v17, 0
    v_dot2_f32_bf16 v61, v101, v17, 0
    v_dot2_f32_bf16 v65, v105, v17, 0
    v_dot2_f32_bf16 v62, v102, v17, 0
    v_dot2_f32_bf16 v66, v106, v17, 0
    v_dot2_f32_bf16 v63, v103, v17, 0
    v_dot2_f32_bf16 v67, v107, v17, 0
    v_permlane32_swap_b32 v60, v64
    v_permlane32_swap_b32 v61, v65
    v_permlane32_swap_b32 v62, v66
    v_permlane32_swap_b32 v63, v67
    v_add_f32 v60, v60, v64
    v_add_f32 v62, v62, v66
    v_add_f32 v61, v61, v65
    v_add_f32 v63, v63, v67
    v_permlane16_swap_b32 v60, v62
    v_add_f32 v60, v60, v62
    v_permlane16_swap_b32 v61, v63
    v_add_f32 v61, v61, v63
    v_add_f32_dpp v9, v60, v60 row_ror:8 row_mask:0xf bank_mask:0x3
    s_nop 0
    v_add_f32_dpp v9, v61, v61 row_ror:8 row_mask:0xf bank_mask:0xc
    ds_write_b32 v23, v9 offset:2560
    s_mov_b64 exec, 0xf
    s_waitcnt lgkmcnt(0)
    s_barrier
    ds_read_b128 v[100:103], v25 offset:2560
    ds_read_b128 v[104:107], v25 offset:2816
    ds_read_b128 v[108:111], v25 offset:3072
    ds_read_b128 v[112:115], v25 offset:3328
    s_waitcnt lgkmcnt(2)
    v_pk_add_f32 v[100:101], v[100:101], v[104:105]
    v_pk_add_f32 v[102:103], v[102:103], v[106:107]
    s_waitcnt lgkmcnt(0)
    v_pk_add_f32 v[108:109], v[108:109], v[112:113]
    v_pk_add_f32 v[110:111], v[110:111], v[114:115]
    v_pk_add_f32 v[100:101], v[100:101], v[108:109]
    v_pk_add_f32 v[102:103], v[102:103], v[110:111]
    v_and_or_b32 v100, v100, s45, v44
    v_and_or_b32 v101, v101, s45, v45
    v_and_or_b32 v102, v102, s45, v46
    v_and_or_b32 v103, v103, s45, v47
    global_store_dwordx4 v27, v[100:103], s[34:35]
    v_mov_b64 v[120:121], v[100:101]
    v_mov_b64 v[122:123], v[102:103]
    s_mov_b32 exec_lo, -1
    global_load_dwordx4 v[68:71], v42, s[34:35] sc1
    s_mov_b64 exec, -1
    global_load_ushort v18, v24, s[24:25]
    global_load_dwordx2 v[54:55], v22, s[34:35] sc1
    s_waitcnt vmcnt(16)
    global_load_dwordx4 v[156:159], v16, s[8:9] nt
    v_xor_b32 v16, 0x80000, v16
    s_waitcnt vmcnt(16)
    global_load_dwordx4 v[160:163], v16, s[8:9] nt
    v_xor_b32 v16, 0xc0000, v16
    global_load_dwordx4 v[236:239], v34, s[34:35] sc1
    global_load_dwordx4 v[240:243], v34, s[34:35] offset:2048 sc1
    s_waitcnt vmcnt(18)
    global_load_dwordx4 v[164:167], v16, s[8:9] nt
    v_xor_b32 v16, 0x80000, v16
    s_waitcnt vmcnt(14)
    global_load_dwordx4 v[168:171], v16, s[8:9] nt
    v_xor_b32 v16, 0xe0000, v16
    s_waitcnt vmcnt(14)
    global_load_dwordx4 v[72:75], v20, s[26:27] offset:0 nt
    s_waitcnt vmcnt(14)
    global_load_dwordx4 v[76:79], v20, s[26:27] offset:1024 nt
    s_waitcnt vmcnt(18)
    v_lshlrev_b32 v100, 16, v188
    v_and_b32 v101, 0xffff0000, v188
    v_lshlrev_b32 v108, 16, v192
    v_and_b32 v109, 0xffff0000, v192
    v_lshlrev_b32 v102, 16, v189
    v_and_b32 v103, 0xffff0000, v189
    v_lshlrev_b32 v110, 16, v193
    v_and_b32 v111, 0xffff0000, v193
    v_lshlrev_b32 v104, 16, v190
    v_and_b32 v105, 0xffff0000, v190
    v_lshlrev_b32 v112, 16, v194
    v_and_b32 v113, 0xffff0000, v194
    v_lshlrev_b32 v106, 16, v191
    v_and_b32 v107, 0xffff0000, v191
    v_lshlrev_b32 v114, 16, v195
    v_and_b32 v115, 0xffff0000, v195
    v_pk_mul_f32 v[100:101], v[100:101], v[108:109]
    v_pk_mul_f32 v[102:103], v[102:103], v[110:111]
    v_pk_mul_f32 v[104:105], v[104:105], v[112:113]
    v_pk_mul_f32 v[106:107], v[106:107], v[114:115]
    v_cvt_pk_bf16_f32 v108, v100, v101
    v_cvt_pk_bf16_f32 v109, v102, v103
    v_cvt_pk_bf16_f32 v110, v104, v105
    v_cvt_pk_bf16_f32 v111, v106, v107
    v_mov_b32 v9, 0x3f803f80
    v_dot2_f32_bf16 v10, v108, v9, 0
    v_dot2_f32_bf16 v10, v109, v9, v10
    v_dot2_f32_bf16 v10, v110, v9, v10
    v_dot2_f32_bf16 v10, v111, v9, v10
    s_nop 2
    v_add_f32_dpp v10, v10, v10 quad_perm:[1,0,3,2] row_mask:0xf bank_mask:0xf
    s_nop 1
    v_add_f32_dpp v10, v10, v10 quad_perm:[2,3,0,1] row_mask:0xf bank_mask:0xf
    s_nop 1
    v_add_f32_dpp v10, v10, v10 row_ror:4 row_mask:0xf bank_mask:0xf
    s_nop 1
    v_add_f32_dpp v10, v10, v10 row_ror:8 row_mask:0xf bank_mask:0xf
    s_nop 1
    v_mov_b32 v9, v10
    s_nop 1
    v_permlane16_swap_b32 v10, v9
    v_add_f32 v10, v10, v9
    v_mov_b32 v9, v10
    s_nop 1
    v_permlane32_swap_b32 v10, v9
    v_add_f32 v10, v10, v9
    v_cvt_pk_bf16_f32 v10, v10, v10
    v_lshlrev_b32 v10, 16, v10
    v_mul_f32 v10, 0xbfb8aa3b, v10
    v_exp_f32 v10, v10
    s_nop 0
    v_add_f32 v10, 1.0, v10
    v_rcp_f32 v10, v10
    s_nop 0
    v_cvt_pk_bf16_f32 v10, v10, v10
    v_lshlrev_b32 v52, 16, v10
    v_sub_f32 v9, 1.0, v52
    v_cvt_pk_bf16_f32 v9, v9, v9
    v_lshlrev_b32 v53, 16, v9
    global_load_dwordx4 v[244:247], v34, s[34:35] sc1
    global_load_dwordx4 v[248:251], v34, s[34:35] offset:2048 sc1
    s_waitcnt vmcnt(16)
    global_load_dwordx4 v[172:175], v16, s[8:9] nt
    v_xor_b32 v16, 0x80000, v16
    s_waitcnt vmcnt(10)
    global_load_dwordx4 v[176:179], v16, s[8:9] nt
    v_xor_b32 v16, 0xc0000, v16
    global_load_dwordx4 v[68:71], v19, s[34:35] sc1
    s_mov_b64 exec, 0xf
    global_store_dwordx4 v26, v[116:119], s[58:59] sc1
    global_store_dwordx4 v27, v[120:123], s[58:59] sc1
    s_mov_b64 exec, -1
    s_waitcnt vmcnt(11)
    v_perm_b32 v9, v237, v236, s43
    v_perm_b32 v10, v239, v238, s44
    v_perm_b32 v11, v241, v240, s43
    v_perm_b32 v12, v243, v242, s44
    v_bitop3_b32 v9, v9, v10, s94 bitop3:0x56
    v_bitop3_b32 v11, v11, v12, s94 bitop3:0x56
    v_or_b32 v9, v9, v11
    v_cmp_ne_u32 vcc, 0, v9
    v_and_b32 v236, s45, v236
    v_and_b32 v237, s45, v237
    v_and_b32 v238, s45, v238
    v_and_b32 v239, s45, v239
    v_and_b32 v240, s45, v240
    v_and_b32 v241, s45, v241
    v_and_b32 v242, s45, v242
    v_and_b32 v243, s45, v243
    v_pk_add_f32 v[80:81], v[236:237], v[240:241]
    v_pk_add_f32 v[82:83], v[238:239], v[242:243]
    s_cbranch_vccnz L_qslow
L_qok:
    v_mov_b32 v12, s95
    v_permlane32_swap_b32 v80, v82
    v_permlane32_swap_b32 v81, v83
    v_add_f32 v80, v80, v82
    v_add_f32 v81, v81, v83
    v_cvt_pk_bf16_f32 v80, v80, v81
    ds_write_b32 v35, v80 offset:192
    ds_write_b32 v37, v12 offset:128
    s_waitcnt lgkmcnt(0)
    s_barrier
    ds_read_b128 v[80:83], v38 offset:192
    ds_read_b128 v[116:119], v36 offset:128
    s_waitcnt vmcnt(13)
    global_load_dwordx4 v[180:183], v16, s[8:9] nt
    v_xor_b32 v16, 0x80000, v16
    s_waitcnt vmcnt(11)
    global_load_dwordx4 v[184:187], v16, s[8:9] nt
    s_waitcnt lgkmcnt(1)
    v_mfma_f32_16x16x32_bf16 v[188:191], v[124:127], v[80:83], 0
    v_mfma_f32_16x16x32_bf16 v[192:195], v[128:131], v[80:83], 0
    v_mfma_f32_16x16x32_bf16 v[196:199], v[132:135], v[80:83], 0
    v_mfma_f32_16x16x32_bf16 v[200:203], v[136:139], v[80:83], 0
    s_waitcnt lgkmcnt(0)
    v_or3_b32 v116, v116, v117, v118
    v_or_b32 v116, v116, v119
    v_cmp_ne_u32 s[62:63], 0, v116
    v_mfma_f32_16x16x32_bf16 v[204:207], v[140:143], v[80:83], 0
    v_add_f32_dpp v188, v189, v188 row_ror:12 row_mask:0xf bank_mask:0x1
    v_add_f32_dpp v192, v193, v192 row_ror:12 row_mask:0xf bank_mask:0x1
    v_mfma_f32_16x16x32_bf16 v[208:211], v[144:147], v[80:83], 0
    v_add_f32_dpp v197, v198, v197 row_ror:12 row_mask:0xf bank_mask:0x2
    v_add_f32_dpp v188, v190, v188 row_ror:8 row_mask:0xf bank_mask:0x1
    v_add_f32_dpp v192, v194, v192 row_ror:8 row_mask:0xf bank_mask:0x1
    v_mfma_f32_16x16x32_bf16 v[212:215], v[148:151], v[80:83], 0
    v_add_f32_dpp v197, v199, v197 row_ror:8 row_mask:0xf bank_mask:0x2
    v_add_f32_dpp v56, v191, v188 row_ror:4 row_mask:0xf bank_mask:0x1
    v_add_f32_dpp v57, v195, v192 row_ror:4 row_mask:0xf bank_mask:0x1
    v_mfma_f32_16x16x32_bf16 v[216:219], v[152:155], v[80:83], 0
    v_add_f32_dpp v56, v196, v197 row_ror:4 row_mask:0xf bank_mask:0x2
    v_add_f32_dpp v201, v202, v201 row_ror:12 row_mask:0xf bank_mask:0x2
    v_add_f32_dpp v206, v207, v206 row_ror:12 row_mask:0xf bank_mask:0x4
    v_add_f32_dpp v210, v211, v210 row_ror:12 row_mask:0xf bank_mask:0x4
    v_add_f32_dpp v201, v203, v201 row_ror:8 row_mask:0xf bank_mask:0x2
    v_add_f32_dpp v206, v204, v206 row_ror:8 row_mask:0xf bank_mask:0x4
    v_add_f32_dpp v210, v208, v210 row_ror:8 row_mask:0xf bank_mask:0x4
    v_add_f32_dpp v215, v212, v215 row_ror:12 row_mask:0xf bank_mask:0x8
    v_add_f32_dpp v219, v216, v219 row_ror:12 row_mask:0xf bank_mask:0x8
    v_add_f32_dpp v57, v200, v201 row_ror:4 row_mask:0xf bank_mask:0x2
    v_add_f32_dpp v215, v213, v215 row_ror:8 row_mask:0xf bank_mask:0x8
    v_add_f32_dpp v219, v217, v219 row_ror:8 row_mask:0xf bank_mask:0x8
    v_add_f32_dpp v56, v205, v206 row_ror:4 row_mask:0xf bank_mask:0x4
    v_add_f32_dpp v56, v214, v215 row_ror:4 row_mask:0xf bank_mask:0x8
    v_add_f32_dpp v57, v218, v219 row_ror:4 row_mask:0xf bank_mask:0x8
    v_add_f32_dpp v57, v209, v210 row_ror:4 row_mask:0xf bank_mask:0x4
    v_cvt_pk_bf16_f32 v9, v56, v57
    v_lshlrev_b32 v56, 16, v9
    v_and_b32 v57, 0xffff0000, v9
    v_mul_f32 v56, s47, v56
    v_mul_f32 v57, s47, v57
    v_cvt_pk_bf16_f32 v9, v56, v57
    v_lshlrev_b32 v56, 16, v9
    v_and_b32 v57, 0xffff0000, v9
    v_max_f32 v9, v56, v57
    v_perm_b32 v124, v160, v156, s41
    v_perm_b32 v126, v160, v156, s42
    v_max_f32_dpp v9, v9, v9 row_ror:4 row_mask:0xf bank_mask:0xf
    v_perm_b32 v128, v161, v157, s41
    v_perm_b32 v130, v161, v157, s42
    v_max_f32_dpp v10, v9, v9 row_ror:8 row_mask:0xf bank_mask:0xf
    v_max_f32_dpp v9, v9, v9 row_ror:8 row_mask:0xf bank_mask:0xf
    v_perm_b32 v132, v162, v158, s41
    v_perm_b32 v134, v162, v158, s42
    v_permlane16_swap_b32 v9, v10
    v_max_f32 v11, v9, v10
    v_max_f32 v9, v9, v10
    v_perm_b32 v136, v163, v159, s41
    v_perm_b32 v138, v163, v159, s42
    v_permlane32_swap_b32 v9, v11
    v_max_f32 v9, v9, v11
    v_mul_f32 v41, s48, v9
    v_fma_f32 v56, v56, s48, -v41
    v_fma_f32 v57, v57, s48, -v41
    v_exp_f32 v56, v56
    v_exp_f32 v57, v57
    s_cmp_lg_u64 s[62:63], 0
    v_add_f32 v9, v56, v57
    s_nop 0
    s_nop 0
    v_add_f32_dpp v9, v9, v9 row_ror:4 row_mask:0xf bank_mask:0xf
    s_nop 0
    s_nop 0
    v_add_f32_dpp v10, v9, v9 row_ror:8 row_mask:0xf bank_mask:0xf
    v_add_f32_dpp v9, v9, v9 row_ror:8 row_mask:0xf bank_mask:0xf
    s_nop 0
    s_nop 0
    v_permlane16_swap_b32 v9, v10
    v_add_f32 v11, v9, v10
    v_add_f32 v9, v9, v10
    s_nop 0
    s_nop 0
    v_permlane32_swap_b32 v9, v11
    v_add_f32 v9, v9, v11
    s_mov_b64 exec, 0xf
    ds_write2_b32 v37, v41, v9 offset0:0 offset1:16
    s_mov_b64 exec, -1
    s_cselect_b64 s[16:17], s[58:59], s[34:35]
    s_waitcnt lgkmcnt(0)
    s_barrier
    ds_read_b128 v[80:83], v36 offset:0
    ds_read_b128 v[116:119], v36 offset:64
    s_waitcnt vmcnt(11)
    v_perm_b32 v125, v168, v164, s41
    v_perm_b32 v127, v168, v164, s42
    v_perm_b32 v129, v169, v165, s41
    v_perm_b32 v131, v169, v165, s42
    v_perm_b32 v133, v170, v166, s41
    v_perm_b32 v135, v170, v166, s42
    v_perm_b32 v137, v171, v167, s41
    v_perm_b32 v139, v171, v167, s42
    s_waitcnt lgkmcnt(1)
    v_max3_f32 v9, v80, v81, v82
    v_max_f32 v9, v9, v83
    v_sub_f32 v80, v80, v9
    v_sub_f32 v81, v81, v9
    v_sub_f32 v82, v82, v9
    v_sub_f32 v83, v83, v9
    v_sub_f32 v41, v41, v9
    v_exp_f32 v80, v80
    v_exp_f32 v81, v81
    v_exp_f32 v82, v82
    v_exp_f32 v83, v83
    v_exp_f32 v41, v41
    s_waitcnt lgkmcnt(0)
    v_pk_mul_f32 v[116:117], v[116:117], v[80:81]
    v_pk_fma_f32 v[116:117], v[118:119], v[82:83], v[116:117]
    v_add_f32 v116, v116, v117
    v_rcp_f32 v117, v116
    v_log_f32 v10, v116
    v_mul_f32 v41, v41, v117
    v_add_f32 v10, v10, v9
    v_mul_f32 v56, v56, v41
    v_mul_f32 v57, v57, v41
    v_readlane_b32 s51, v10, s100
    v_cvt_pk_bf16_f32 v12, v56, v57
    v_mov_b32 v57, s37
    v_mov_b32 v56, s51
    v_mov_b32_dpp v220, v12 quad_perm:[0,1,2,3] row_mask:0xf bank_mask:0x1
    v_mov_b32_dpp v221, v12 row_ror:12 row_mask:0xf bank_mask:0x1
    v_mov_b32_dpp v222, v12 row_ror:4 row_mask:0xf bank_mask:0x2
    v_mov_b32_dpp v223, v12 quad_perm:[0,1,2,3] row_mask:0xf bank_mask:0x2
    v_mov_b32_dpp v224, v12 row_ror:8 row_mask:0xf bank_mask:0x4
    v_mov_b32_dpp v225, v12 row_ror:4 row_mask:0xf bank_mask:0x4
    v_mov_b32_dpp v226, v12 row_ror:12 row_mask:0xf bank_mask:0x8
    v_mov_b32_dpp v227, v12 row_ror:8 row_mask:0xf bank_mask:0x8
    v_and_b32 v80, 0xffff, v12
    v_lshlrev_b32 v81, 16, v12
    v_lshrrev_b32 v82, 16, v12
    v_and_b32 v83, 0xffff0000, v12
    v_mov_b32_dpp v228, v12 row_ror:8 row_mask:0xf bank_mask:0x1
    v_mov_b32_dpp v229, v12 row_ror:12 row_mask:0xf bank_mask:0x2
    v_mov_b32_dpp v230, v12 quad_perm:[0,1,2,3] row_mask:0xf bank_mask:0x4
    v_mov_b32_dpp v231, v12 row_ror:4 row_mask:0xf bank_mask:0x8
    v_mov_b32_dpp v232, v80 row_ror:4 row_mask:0xf bank_mask:0x1
    v_mov_b32_dpp v232, v81 row_ror:8 row_mask:0xf bank_mask:0x2
    v_mov_b32_dpp v233, v80 row_ror:12 row_mask:0xf bank_mask:0x4
    v_mov_b32_dpp v233, v81 quad_perm:[0,1,2,3] row_mask:0xf bank_mask:0x8
    v_mov_b32_dpp v234, v82 row_ror:4 row_mask:0xf bank_mask:0x1
    v_mov_b32_dpp v234, v83 row_ror:8 row_mask:0xf bank_mask:0x2
    v_mov_b32_dpp v235, v82 row_ror:12 row_mask:0xf bank_mask:0x4
    v_mov_b32_dpp v235, v83 quad_perm:[0,1,2,3] row_mask:0xf bank_mask:0x8
    s_mov_b64 exec, 0xff
    s_cbranch_scc1 L_rpm
    global_store_dwordx2 v43, v[56:57], s[34:35]
L_rpmd:
    s_mov_b64 exec, -1
    s_nop 1
    v_mfma_f32_16x16x32_bf16 v[188:191], v[124:127], v[220:223], 0
    v_mfma_f32_16x16x32_bf16 v[192:195], v[132:135], v[220:223], 0
    v_mfma_f32_16x16x32_bf16 v[188:191], v[128:131], v[224:227], v[188:191]
    v_mfma_f32_16x16x32_bf16 v[192:195], v[136:139], v[224:227], v[192:195]
    s_waitcnt vmcnt(10)
    v_perm_b32 v100, v76, v72, s18
    v_perm_b32 v101, v76, v72, s19
    v_perm_b32 v102, v77, v73, s18
    v_perm_b32 v103, v77, v73, s19
    v_perm_b32 v104, v78, v74, s18
    v_perm_b32 v105, v78, v74, s19
    v_perm_b32 v106, v79, v75, s18
    v_perm_b32 v107, v79, v75, s19
    s_mov_b32 exec_hi, 0
    global_atomic_add v33, v28, v48, s[34:35] sc0 sc1
    s_mov_b64 exec, -1
    s_waitcnt vmcnt(13)
    global_load_dwordx4 v[84:87], v3, s[12:13] offset:-4096 nt
    s_waitcnt vmcnt(13)
    global_load_dwordx4 v[88:91], v4, s[12:13] offset:-4096 nt
    s_waitcnt vmcnt(9)
    v_perm_b32 v140, v176, v172, s41
    v_perm_b32 v141, v176, v172, s42
    v_perm_b32 v142, v177, v173, s41
    v_perm_b32 v143, v177, v173, s42
    v_perm_b32 v144, v178, v174, s41
    v_perm_b32 v145, v178, v174, s42
    v_perm_b32 v146, v179, v175, s41
    v_perm_b32 v147, v179, v175, s42
    v_mfma_f32_16x16x32_bf16 v[188:191], v[140:143], v[228:231], v[188:191]
    s_nop 0
    v_mfma_f32_16x16x32_bf16 v[192:195], v[144:147], v[228:231], v[192:195]
    s_nop 3
    s_waitcnt vmcnt(13)
    global_load_dwordx4 v[92:95], v3, s[12:13] offset:0 nt
    s_waitcnt vmcnt(11)
    global_load_dwordx4 v[96:99], v4, s[12:13] offset:0 nt
    s_waitcnt vmcnt(10)
L_hchk:
    v_perm_b32 v9, v69, v68, s43
    v_perm_b32 v10, v71, v70, s44
    v_or_b32 v9, v9, v10
    v_cmp_ne_u32 vcc, s37, v9
    v_and_b32 v68, s45, v68
    v_and_b32 v69, s45, v69
    v_and_b32 v70, s45, v70
    v_and_b32 v71, s45, v71
    s_cbranch_vccnz L_hslow
L_hok:
    v_add_f32_dpp v9, v68, v68 row_ror:8 row_mask:0xf bank_mask:0x3
    v_add_f32_dpp v10, v69, v69 row_ror:8 row_mask:0xf bank_mask:0x3
    v_add_f32_dpp v9, v70, v70 row_ror:8 row_mask:0xf bank_mask:0xc
    v_add_f32_dpp v10, v71, v71 row_ror:8 row_mask:0xf bank_mask:0xc
    v_lshlrev_b32 v18, 16, v18
    v_add_f32_dpp v68, v9, v9 row_half_mirror row_mask:0xf bank_mask:0x5
    v_add_f32_dpp v68, v10, v10 row_half_mirror row_mask:0xf bank_mask:0xa
    s_nop 1
    v_add_f32_dpp v68, v68, v68 quad_perm:[2,3,0,1] row_mask:0xf bank_mask:0xf
    v_cvt_pk_bf16_f32 v68, v68, v68
    v_lshlrev_b32 v68, 16, v68
    v_add_f32 v68, v68, v18
    v_cvt_pk_bf16_f32 v68, v68, v68
    v_lshlrev_b32 v68, 16, v68
    v_mul_f32 v69, s48, v68
    v_exp_f32 v69, -|v69|
    v_cmp_lt_f32 vcc, 0, v68
    v_add_f32 v70, v69, v69
    v_mul_f32 v69, v69, v69
    v_add_f32 v71, v69, v69
    v_cndmask_b32 v69, v69, 1.0, vcc
    v_cndmask_b32 v71, 2.0, v71, vcc
    v_add_f32 v69, v69, v70
    v_add_f32 v71, v71, v69
    v_rcp_f32 v71, v71
    v_mul_f32 v69, v69, v68
    v_mul_f32 v69, v69, v53
    v_mul_f32 v68, v69, v71
    v_mul_f32 v70, v69, v71
    v_mul_f32 v69, v69, v71
    s_nop 0
    v_mov_b32_dpp v69, v68 row_half_mirror row_mask:0xf bank_mask:0xa
    v_mov_b32_dpp v70, v68 row_half_mirror row_mask:0xf bank_mask:0x5
    v_cvt_pk_bf16_f32 v68, v69, v70
    v_and_b32 v68, s36, v68
    v_dot2_f32_bf16 v60, v100, v68, 0
    v_dot2_f32_bf16 v61, v101, v68, 0
    v_dot2_f32_bf16 v62, v102, v68, 0
    v_dot2_f32_bf16 v63, v103, v68, 0
    v_dot2_f32_bf16 v64, v104, v68, 0
    v_dot2_f32_bf16 v65, v105, v68, 0
    v_dot2_f32_bf16 v66, v106, v68, 0
    v_dot2_f32_bf16 v67, v107, v68, 0
    s_waitcnt vmcnt(7)
    v_mfma_f32_16x16x16_bf16 v[188:191], v[180:181], v[232:233], v[188:191]
    v_mfma_f32_16x16x16_bf16 v[192:195], v[182:183], v[232:233], v[192:195]
    s_waitcnt vmcnt(6)
    v_mfma_f32_16x16x16_bf16 v[188:191], v[184:185], v[234:235], v[188:191]
    v_mfma_f32_16x16x16_bf16 v[192:195], v[186:187], v[234:235], v[192:195]
    global_load_dwordx2 v[54:55], v22, s[16:17] sc1
    s_cmp_lg_u64 s[62:63], 0
    s_nop 4
    ds_write_b128 v39, v[188:191] offset:4608
    ds_write_b128 v39, v[192:195] offset:4672
    s_mov_b32 exec_hi, 0
    s_waitcnt lgkmcnt(0)
    s_barrier
    ds_read_b128 v[156:159], v40 offset:4608
    ds_read_b128 v[160:163], v40 offset:6784
    ds_read_b128 v[164:167], v40 offset:8960
    ds_read_b128 v[168:171], v40 offset:11136
    s_waitcnt lgkmcnt(2)
    v_pk_add_f32 v[156:157], v[156:157], v[160:161]
    v_pk_add_f32 v[158:159], v[158:159], v[162:163]
    s_waitcnt lgkmcnt(0)
    v_pk_add_f32 v[164:165], v[164:165], v[168:169]
    v_pk_add_f32 v[166:167], v[166:167], v[170:171]
    v_pk_add_f32 v[156:157], v[156:157], v[164:165]
    v_pk_add_f32 v[158:159], v[158:159], v[166:167]
    v_and_or_b32 v156, v156, s45, v44
    v_and_or_b32 v157, v157, s45, v45
    v_and_or_b32 v158, v158, s45, v46
    v_and_or_b32 v159, v159, s45, v47
    s_cbranch_scc1 L_rpub
    global_store_dwordx4 v42, v[156:159], s[34:35]
L_rpubd:
    s_mov_b64 exec, -1
    s_waitcnt vmcnt(1)
L_pmchk:
    v_cmp_ne_u32 vcc, s37, v55
    v_max_f32_dpp v9, v54, v54 quad_perm:[1,0,3,2] row_mask:0xf bank_mask:0xf
    s_cbranch_vccnz L_pmslow
L_pmok:
    global_load_dwordx4 v[172:175], v21, s[16:17] offset:0 sc1
    global_load_dwordx4 v[176:179], v21, s[16:17] offset:1024 sc1
    global_load_dwordx4 v[180:183], v21, s[16:17] offset:2048 sc1
    global_load_dwordx4 v[184:187], v21, s[16:17] offset:3072 sc1
    v_max_f32_dpp v9, v9, v9 quad_perm:[2,3,0,1] row_mask:0xf bank_mask:0xf
    v_perm_b32 v204, v96, v92, s41
    v_perm_b32 v205, v96, v92, s42
    v_max_f32_dpp v10, v9, v9 row_ror:8 row_mask:0xf bank_mask:0xf
    v_max_f32_dpp v9, v9, v9 row_ror:8 row_mask:0xf bank_mask:0xf
    v_perm_b32 v206, v97, v93, s41
    v_perm_b32 v207, v97, v93, s42
    v_permlane16_swap_b32 v9, v10
    v_max_f32 v12, v9, v10
    v_max_f32 v9, v9, v10
    v_perm_b32 v208, v98, v94, s41
    v_perm_b32 v209, v98, v94, s42
    v_permlane32_swap_b32 v9, v12
    v_max_f32 v9, v9, v12
    v_sub_f32 v12, v54, v9
    v_exp_f32 v12, v12
    v_perm_b32 v210, v99, v95, s41
    v_perm_b32 v196, v88, v84, s41
    v_add_f32_dpp v9, v12, v12 quad_perm:[1,0,3,2] row_mask:0xf bank_mask:0xf
    v_perm_b32 v197, v88, v84, s42
    v_perm_b32 v198, v89, v85, s41
    v_add_f32_dpp v9, v9, v9 quad_perm:[2,3,0,1] row_mask:0xf bank_mask:0xf
    v_perm_b32 v199, v89, v85, s42
    v_perm_b32 v200, v90, v86, s41
    v_add_f32_dpp v10, v9, v9 row_ror:8 row_mask:0xf bank_mask:0xf
    v_add_f32_dpp v9, v9, v9 row_ror:8 row_mask:0xf bank_mask:0xf
    v_perm_b32 v201, v90, v86, s42
    v_perm_b32 v202, v91, v87, s41
    v_permlane16_swap_b32 v9, v10
    v_add_f32 v11, v9, v10
    v_add_f32 v9, v9, v10
    v_perm_b32 v203, v91, v87, s42
    v_mul_f32 v12, v12, v52
    v_permlane32_swap_b32 v9, v11
    v_add_f32 v9, v9, v11
    v_rcp_f32 v9, v9
    v_perm_b32 v211, v99, v95, s42
    v_mul_f32 v12, v12, v9
    s_nop 1
    v_mov_b32_dpp v116, v12 quad_perm:[0,0,0,0] row_mask:0xf bank_mask:0xf
    v_mov_b32_dpp v117, v12 quad_perm:[1,1,1,1] row_mask:0xf bank_mask:0xf
    v_mov_b32_dpp v118, v12 quad_perm:[2,2,2,2] row_mask:0xf bank_mask:0xf
    v_mov_b32_dpp v119, v12 quad_perm:[3,3,3,3] row_mask:0xf bank_mask:0xf
L_vchk:
    v_subrev_u32 v9, s20, v33
    v_cmp_lt_u32 vcc, 31, v9
    s_andn2_b32 vcc_lo, vcc_lo, s32
    s_cbranch_scc1 L_vslow
L_vok:
    s_branch L_o2w
L_o2retry:
    s_mov_b64 exec, vcc
    global_load_dwordx4 v[172:175], v21, s[16:17] offset:0 sc1
    global_load_dwordx4 v[176:179], v21, s[16:17] offset:1024 sc1
    global_load_dwordx4 v[180:183], v21, s[16:17] offset:2048 sc1
    global_load_dwordx4 v[184:187], v21, s[16:17] offset:3072 sc1
    s_mov_b64 exec, -1
    s_add_u32 s46, s46, 1
    s_cmp_gt_u32 s46, 100000
    s_cbranch_scc1 L_o2go
L_o2w:
    s_waitcnt vmcnt(3)
    v_xor_b32 v124, v44, v172
    v_xor_b32 v125, v45, v173
    v_xor_b32 v126, v46, v174
    v_xor_b32 v127, v47, v175
    v_pk_mul_f32 v[80:81], v[124:125], v[116:117] op_sel_hi:[1,0]
    v_pk_mul_f32 v[82:83], v[126:127], v[116:117] op_sel_hi:[1,0]
    s_waitcnt vmcnt(2)
    v_xor_b32 v128, v44, v176
    v_xor_b32 v129, v45, v177
    v_xor_b32 v130, v46, v178
    v_xor_b32 v131, v47, v179
    v_pk_fma_f32 v[80:81], v[128:129], v[116:117], v[80:81] op_sel:[0,1,0] op_sel_hi:[1,1,1]
    v_pk_fma_f32 v[82:83], v[130:131], v[116:117], v[82:83] op_sel:[0,1,0] op_sel_hi:[1,1,1]
    s_waitcnt vmcnt(1)
    v_or3_b32 v120, v124, v125, v126
    v_xor_b32 v132, v44, v180
    v_xor_b32 v133, v45, v181
    v_xor_b32 v134, v46, v182
    v_xor_b32 v135, v47, v183
    v_pk_fma_f32 v[80:81], v[132:133], v[118:119], v[80:81] op_sel_hi:[1,0,1]
    v_pk_fma_f32 v[82:83], v[134:135], v[118:119], v[82:83] op_sel_hi:[1,0,1]
    s_waitcnt vmcnt(0)
    v_xor_b32 v136, v44, v184
    v_xor_b32 v137, v45, v185
    v_xor_b32 v138, v46, v186
    v_xor_b32 v139, v47, v187
    v_pk_fma_f32 v[80:81], v[136:137], v[118:119], v[80:81] op_sel:[0,1,0] op_sel_hi:[1,1,1]
    v_pk_fma_f32 v[82:83], v[138:139], v[118:119], v[82:83] op_sel:[0,1,0] op_sel_hi:[1,1,1]
    v_or3_b32 v120, v120, v127, v128
    v_or3_b32 v120, v120, v129, v130
    v_permlane32_swap_b32 v80, v82
    v_permlane32_swap_b32 v81, v83
    v_add_f32 v80, v80, v82
    v_add_f32 v81, v81, v83
    v_or3_b32 v120, v120, v131, v132
    v_or3_b32 v120, v120, v133, v134
    v_permlane16_swap_b32 v80, v81
    v_add_f32 v80, v80, v81
    v_or3_b32 v120, v120, v135, v136
    v_or3_b32 v120, v120, v137, v138
    v_add_f32_dpp v81, v80, v80 row_ror:8 row_mask:0xf bank_mask:0xf
    v_add_f32_dpp v80, v80, v80 row_ror:8 row_mask:0xf bank_mask:0xf
    v_or_b32 v120, v120, v139
    v_cmp_ne_u32_sdwa vcc, v120, v48 src0_sel:BYTE_0 src1_sel:DWORD
    v_permlane16_swap_b32 v80, v81
    v_cvt_pk_bf16_f32 v80, v80, v81
    s_cbranch_vccnz L_o2retry
L_o2go:
    s_nop 0
    v_mov_b32_dpp v10, v80 row_newbcast:0 row_mask:0x5 bank_mask:0x3
    v_mov_b32_dpp v11, v80 row_newbcast:4 row_mask:0x5 bank_mask:0x3
    v_mov_b32_dpp v10, v80 row_newbcast:1 row_mask:0x5 bank_mask:0xc
    v_mov_b32_dpp v11, v80 row_newbcast:5 row_mask:0x5 bank_mask:0xc
    v_mov_b32_dpp v10, v80 row_newbcast:2 row_mask:0xa bank_mask:0x3
    v_mov_b32_dpp v11, v80 row_newbcast:6 row_mask:0xa bank_mask:0x3
    v_mov_b32_dpp v10, v80 row_newbcast:3 row_mask:0xa bank_mask:0xc
    v_mov_b32_dpp v11, v80 row_newbcast:7 row_mask:0xa bank_mask:0xc
    v_dot2c_f32_bf16 v60, v196, v10
    v_dot2c_f32_bf16 v64, v200, v10
    v_dot2c_f32_bf16 v61, v197, v10
    v_dot2c_f32_bf16 v65, v201, v10
    v_dot2c_f32_bf16 v62, v198, v10
    v_dot2c_f32_bf16 v66, v202, v10
    v_dot2c_f32_bf16 v63, v199, v10
    v_dot2c_f32_bf16 v67, v203, v10
    v_dot2c_f32_bf16 v60, v204, v11
    v_dot2c_f32_bf16 v64, v208, v11
    v_dot2c_f32_bf16 v61, v205, v11
    v_dot2c_f32_bf16 v65, v209, v11
    v_dot2c_f32_bf16 v62, v206, v11
    v_dot2c_f32_bf16 v66, v210, v11
    v_dot2c_f32_bf16 v63, v207, v11
    v_dot2c_f32_bf16 v67, v211, v11
    v_permlane32_swap_b32 v60, v64
    v_permlane32_swap_b32 v61, v65
    v_permlane32_swap_b32 v62, v66
    v_permlane32_swap_b32 v63, v67
    v_add_f32 v60, v60, v64
    v_add_f32 v62, v62, v66
    v_add_f32 v61, v61, v65
    v_add_f32 v63, v63, v67
    v_permlane16_swap_b32 v60, v62
    v_add_f32 v60, v60, v62
    v_permlane16_swap_b32 v61, v63
    v_add_f32 v61, v61, v63
    v_add_f32_dpp v9, v60, v60 row_ror:8 row_mask:0xf bank_mask:0x3
    s_nop 0
    v_add_f32_dpp v9, v61, v61 row_ror:8 row_mask:0xf bank_mask:0xc
    ds_write_b32 v23, v9 offset:3584
    s_mov_b64 exec, s[32:33]
    s_add_u32 s20, s20, 31
    s_waitcnt lgkmcnt(0)
    s_barrier
    ds_read2st64_b32 v[100:101], v30 offset0:14 offset1:15
    ds_read2st64_b32 v[102:103], v30 offset0:16 offset1:17
    s_waitcnt lgkmcnt(0)
    v_pk_add_f32 v[100:101], v[100:101], v[102:103]
    v_add_f32 v32, v100, v101
    s_mov_b32 exec_lo, -1
    global_atomic_add_f32 v33, v28, v32, s[34:35] sc0 sc1
    v_mov_b32 v10, s37
    s_add_u32 s38, s99, s100
    s_waitcnt vmcnt(0)
    v_cmp_eq_u32 vcc, s20, v33
    v_add_f32 v32, v32, v33
    s_lshr_b32 vcc_lo, vcc_lo, 4
    v_cvt_pk_bf16_f32 v32, v32, v32
    s_and_b32 exec_lo, vcc_lo, s32
    s_cbranch_scc0 L_fin
    global_store_short v31, v32, s[30:31]
    s_cmp_eq_u32 s38, 0
    s_cbranch_scc0 L_fin
    global_store_dword v48, v10, s[34:35] offset:0
L_fin:
L_end:
    s_endpgm
L_pmslow:
    s_add_u32 s46, s46, 1
    s_cmp_gt_u32 s46, 100000
    s_cbranch_scc1 L_pmok
    global_load_dwordx2 v[54:55], v22, s[16:17] sc1
    s_waitcnt vmcnt(1)
    v_cmp_ne_u32 vcc, s37, v55
    s_cbranch_vccnz L_pmslow
    s_nop 3
    s_branch L_pmchk
L_vslow:
    s_add_u32 s46, s46, 1
    s_cmp_gt_u32 s46, 100000
    s_cbranch_scc1 L_vok
    s_mov_b32 exec_hi, 0
    global_atomic_add v33, v28, v48, s[34:35] sc0 sc1
    s_mov_b64 exec, -1
    s_waitcnt vmcnt(0)
    s_branch L_vchk
L_rpub:
    global_store_dwordx4 v42, v[156:159], s[58:59] sc1
    s_branch L_rpubd
L_rpm:
    global_store_dwordx2 v43, v[56:57], s[58:59] sc1
    s_branch L_rpmd
L_hslow:
    s_add_u32 s46, s46, 1
    s_cmp_gt_u32 s46, 100000
    s_cbranch_scc1 L_hok
    s_cmp_gt_u32 s46, 32
    s_cselect_b64 s[56:57], s[58:59], s[34:35]
    global_load_dwordx4 v[68:71], v19, s[56:57] sc1
    s_waitcnt vmcnt(0)
    s_branch L_hchk
L_qslow:
    s_waitcnt vmcnt(5)
L_qretry:
    v_perm_b32 v9, v245, v244, s43
    v_perm_b32 v10, v247, v246, s44
    v_perm_b32 v11, v249, v248, s43
    v_perm_b32 v12, v251, v250, s44
    v_bitop3_b32 v9, v9, v10, s94 bitop3:0x56
    v_bitop3_b32 v11, v11, v12, s94 bitop3:0x56
    v_or_b32 v9, v9, v11
    v_cmp_ne_u32 vcc, 0, v9
    v_and_b32 v244, s45, v244
    v_and_b32 v245, s45, v245
    v_and_b32 v246, s45, v246
    v_and_b32 v247, s45, v247
    v_and_b32 v248, s45, v248
    v_and_b32 v249, s45, v249
    v_and_b32 v250, s45, v250
    v_and_b32 v251, s45, v251
    v_pk_add_f32 v[80:81], v[244:245], v[248:249]
    v_pk_add_f32 v[82:83], v[246:247], v[250:251]
    s_cbranch_vccz L_qok
    v_cmp_lt_u32 vcc, 15, v9
    s_mov_b32 s95, 1
    s_cbranch_vccz L_qok
    s_mov_b32 s95, 0
    s_add_u32 s46, s46, 1
    s_cmp_gt_u32 s46, 100000
    s_cbranch_scc1 L_qok
    s_cmp_gt_u32 s46, 32
    s_cselect_b64 s[56:57], s[58:59], s[34:35]
    global_load_dwordx4 v[244:247], v34, s[56:57] sc1
    global_load_dwordx4 v[248:251], v34, s[56:57] offset:2048 sc1
    s_waitcnt vmcnt(0)
    s_branch L_qretry
.if (. - L_start) < 6272
.error "the 6 KiB code prefetch of the entry must stay inside .text"
.endif
    s_endpgm
.section .rodata,"a"
.p2align 6
.amdhsa_kernel gated_mix__sliding_block_cached__dense_activation_mish__decode_kernel
  .amdhsa_next_free_vgpr 252
  .amdhsa_next_free_sgpr 102
  .amdhsa_accum_offset 252
  .amdhsa_group_segment_fixed_size 0
  .amdhsa_kernarg_size 104
  .amdhsa_user_sgpr_count 2
  .amdhsa_user_sgpr_kernarg_segment_ptr 1
  .amdhsa_system_sgpr_workgroup_id_x 1
  .amdhsa_float_denorm_mode_32 3
.end_amdhsa_kernel
```
